```python
import torch

def _softmax(x, axis=-1):
    return torch.softmax(x, dim=axis)
def _gelu(x):
    return torch.nn.functional.gelu(x, approximate="tanh")
def _silu(x):
    return torch.nn.functional.silu(x)
def _sigmoid(x):
    return torch.sigmoid(x)
def _layernorm(x, axis=-1, eps=1e-5):
    m = x.mean(dim=axis, keepdim=True)
    v = x.var(dim=axis, keepdim=True, unbiased=False)
    return (x - m) / torch.sqrt(v + eps)
def _scatter_add(tgt, idx, src, axis=0):
    return tgt.clone().index_add_(axis, idx, src)
def _segment_sum(src, seg, n):
    out = torch.zeros((n,) + src.shape[1:], dtype=src.dtype)
    return out.index_add_(0, seg, src)
def _pad(x, pw):
    flat = tuple(v for pair in reversed(pw) for v in pair)
    return torch.nn.functional.pad(x, flat)

kernel_name = 'recurrent_scan__sliding_block_cached__glu_gated_reglu__decode'

def setup_inputs():

    _w = (lambda a: (lambda t: t.to(torch.bfloat16) if t.is_floating_point() else t)(torch.as_tensor(a)))
    def _A_setup():
        B, Sq, D = 8, 1, 512
        Hq, Hkv, Sk, Dh = 32, 8, 4096, 128
        assert Hq % Hkv == 0, (Hq, Hkv)
        return {
            "x": _w((lambda *s: torch.randn(*s, dtype=torch.bfloat16) * 0.05)(B, Sq, D)),
            "k_cache": _w((lambda *s: torch.randn(*s, dtype=torch.bfloat16) * 1.6)(B, Hkv, Sk, Dh)),
            "v_cache": _w((lambda *s: torch.randn(*s, dtype=torch.bfloat16) * 1.6)(B, Hkv, Sk, Dh)),
            "wq": _w((lambda *s: torch.randn(*s, dtype=torch.bfloat16) * 1.6)(D, Hq * Dh) * (D ** -0.5)),
            "wo": _w((lambda *s: torch.randn(*s, dtype=torch.bfloat16) * 1.6)(Hq * Dh, D) * ((Hq * Dh) ** -0.5)),
        }
    _A_in = _A_setup()

    def _B_setup():
        B, S, D, F = 8, 1, 512, 1792
        return {
            "x": _w((lambda *s: torch.randn(*s, dtype=torch.bfloat16) * 0.05)(B, S, D)),
            "W_gate": _w((lambda *s: torch.randn(*s, dtype=torch.bfloat16) * 0.2)(D, F) * (2.0 / D) ** 0.5),
            "W_up": _w((lambda *s: torch.randn(*s, dtype=torch.bfloat16) * 0.2)(D, F) * (2.0 / D) ** 0.5),
            "W_down": _w((lambda *s: torch.randn(*s, dtype=torch.bfloat16) * 0.2)(F, D) * (1.0 / F) ** 0.5),
        }
    _B_in = _B_setup()

    return {
        "A_x": _A_in["x"],
        "A_k_cache": _A_in["k_cache"],
        "A_v_cache": _A_in["v_cache"],
        "A_wq": _A_in["wq"],
        "A_wo": _A_in["wo"],
        "B_x": _B_in["x"],
        "B_W_gate": _B_in["W_gate"],
        "B_W_up": _B_in["W_up"],
        "B_W_down": _B_in["W_down"],
    }

def reference(A_x, A_k_cache, A_v_cache, A_wq, A_wo, B_x, B_W_gate, B_W_up, B_W_down):
    def _A_ref(x, k_cache, v_cache, wq, wo):
        B, Sq, D = x.shape
        Hq, Dh = 32, 128
        Hkv, Sk = k_cache.shape[1], k_cache.shape[2]
        W = min(4096, max(256, Sk // 4))
        rep = Hq // Hkv
        q = (lambda x, *d: x.permute(*d))((x @ wq).reshape(B, Sq, Hq, Dh), 0, 2, 1, 3)
        k = (lambda x, n, axis: torch.repeat_interleave(x, n, dim=axis))(k_cache[:, :, Sk - W:, :], rep, axis=1)
        v = (lambda x, n, axis: torch.repeat_interleave(x, n, dim=axis))(v_cache[:, :, Sk - W:, :], rep, axis=1)
        scores = torch.einsum("bhqd,bhkd->bhqk", q, k) * (Dh ** -0.5)
        p = _softmax(scores, axis=-1)
        o = torch.einsum("bhqk,bhkd->bhqd", p, v)
        return (lambda x, *d: x.permute(*d))(o, 0, 2, 1, 3).reshape(B, Sq, Hq * Dh) @ wo

    def _B_ref(x, W_gate, W_up, W_down):
        gate = torch.einsum("bsd,df->bsf", x, W_gate)
        up = torch.einsum("bsd,df->bsf", x, W_up)
        gate = gate * (lambda x, dt: x.to(dt))(gate > 0, gate.dtype)
        h = gate * up
        return torch.einsum("bsf,fd->bsd", h, W_down)

    x = A_x
    xn = _layernorm(x, axis=-1)
    s = _A_ref(xn, A_k_cache, A_v_cache, A_wq, A_wo)
    g = _silu(_B_ref(xn, B_W_gate, B_W_up, B_W_down))
    return x + s * g
```

```asm
; @launch grid=(256,1,1) block=(768,1,1) lds=44032
.amdgcn_target "amdgcn-amd-amdhsa--gfx950"
.text
.globl recurrent_scan__sliding_block_cached__glu_gated_reglu__decode_kernel
.p2align 8
.type recurrent_scan__sliding_block_cached__glu_gated_reglu__decode_kernel,@function
recurrent_scan__sliding_block_cached__glu_gated_reglu__decode_kernel:
s_cmp_ge_u32 s2, 256
s_cbranch_scc1 L_end
s_load_dwordx16 s[8:23], s[0:1], 0
s_load_dwordx8 s[24:31], s[0:1], 64
v_lshrrev_b32 v2, 6, v0
v_and_b32 v1, 63, v0
v_readfirstlane_b32 s3, v2
s_and_b32 s4, s2, 7
s_lshr_b32 s5, s2, 3
s_lshr_b32 s6, s5, 2
s_and_b32 s7, s5, 3
s_mov_b32 s64, 0x05040100
s_mov_b32 s65, 0x07060302
s_mov_b32 s61, 20000
s_mov_b64 s[92:93], -1
v_and_b32 v6, 15, v1
v_lshrrev_b32 v7, 4, v1
s_cmp_ge_u32 s3, 4
s_cbranch_scc1 L_A
s_setprio 3
v_mov_b32 v2, 0
v_mov_b32 v3, 0
ds_write2_b64 v2, v[2:3], v[2:3] offset0:0 offset1:1
ds_write_b64 v2, v[2:3] offset:16
v_lshlrev_b32 v8, 5, v1
s_lshl_b32 s33, s3, 11
v_lshrrev_b32 v5, 5, v1
v_lshlrev_b32 v5, 2, v5
v_bfe_u32 v11, v1, 1, 4
v_lshl_add_u32 v5, v11, 4, v5
v_and_b32 v11, 1, v1
v_lshl_add_u32 v5, v11, 10, v5
s_lshr_b32 s60, s3, 1
s_lshl_b32 s60, s60, 8
s_and_b32 s62, s3, 1
s_lshl_b32 s62, s62, 3
s_add_u32 s60, s60, s62
v_add_u32 v5, s60, v5
v_and_b32 v3, 1, v7
v_lshlrev_b32 v3, 2, v3
v_lshl_add_u32 v3, v6, 4, v3
v_lshrrev_b32 v11, 5, v1
v_lshl_add_u32 v3, v11, 12, v3
v_add_u32 v3, s60, v3
s_lshl_b32 s90, s4, 15
s_lshl_b32 s60, s6, 12
s_add_u32 s90, s90, s60
s_lshl_b32 s60, s3, 9
s_add_u32 s90, s90, s60
s_add_u32 s90, s90, 65536
v_and_b32 v13, 31, v1
v_lshlrev_b32 v13, 4, v13
v_lshl_add_u32 v0, v11, 11, v13
s_cmp_eq_u32 s4, 0
s_cselect_b32 s91, s5, 0
s_lshl_b32 s91, s91, 1
s_andn2_b32 s91, s91, 31
s_cmp_ge_u32 s91, 30
s_cbranch_scc1 L_S_nop1
s_cmp_ge_u32 s5, 16
s_cbranch_scc1 L_S_ffn
s_mov_b32 s34, 8192
s_lshr_b32 s60, s5, 1
s_lshl_b32 s35, s4, 3
s_add_u32 s35, s35, s60
s_and_b32 s62, s5, 1
s_lshl_b32 s66, s4, 15
s_lshl_b32 s67, s62, 11
s_add_u32 s66, s66, s67
s_lshl_b32 s67, s60, 8
s_add_u32 s66, s66, s67
s_add_u32 s66, s66, 65536
s_mov_b32 s67, 4096
s_waitcnt lgkmcnt(0)
s_mov_b32 s36, s14
s_mov_b32 s37, s15
s_mov_b32 s38, 4194304
s_mov_b32 s39, 0x20000
s_branch L_S_p1
L_S_ffn:
s_mov_b32 s34, 3584
s_mul_i32 s60, s4, 16
s_add_u32 s60, s60, s5
s_sub_u32 s60, s60, 32
s_lshr_b32 s35, s60, 2
s_lshr_b32 s62, s60, 1
s_and_b32 s62, s62, 1
s_and_b32 s63, s60, 1
s_lshl_b32 s66, s63, 1
s_add_u32 s66, s66, s62
s_mul_i32 s66, s66, 7168
s_lshl_b32 s67, s35, 8
s_add_u32 s66, s66, s67
s_add_u32 s66, s66, 1048576
s_mov_b32 s67, 28672
s_waitcnt lgkmcnt(0)
s_cmp_eq_u32 s63, 0
s_cselect_b32 s36, s20, s22
s_cselect_b32 s37, s21, s23
s_mov_b32 s38, 0x1c0000
s_mov_b32 s39, 0x20000
L_S_p1:
s_mov_b32 s40, s8
s_mov_b32 s41, s9
s_mov_b32 s42, 8192
s_mov_b32 s43, 0x20000
buffer_load_dwordx4 v[16:19], v8, s[40:43], s33 offen
buffer_load_dwordx4 v[20:23], v8, s[40:43], s33 offen offset:16
s_lshl_b32 s60, s34, 3
v_mul_lo_u32 v9, v7, s60
v_lshl_add_u32 v9, v6, 3, v9
s_lshl_b32 s63, s62, 2
s_add_u32 s63, s63, s3
s_lshl_b32 s68, s63, 6
s_mul_i32 s68, s68, s34
s_lshl_b32 s35, s35, 7
s_add_u32 s68, s68, s35
s_mul_i32 s69, s34, 25
s_barrier
buffer_load_dwordx2 v[24:25], v9, s[36:39], s68 offen nt
s_add_u32 s68, s68, s34
buffer_load_dwordx2 v[26:27], v9, s[36:39], s68 offen nt
s_add_u32 s68, s68, s34
buffer_load_dwordx2 v[28:29], v9, s[36:39], s68 offen nt
s_add_u32 s68, s68, s34
buffer_load_dwordx2 v[30:31], v9, s[36:39], s68 offen nt
s_add_u32 s68, s68, s34
buffer_load_dwordx2 v[32:33], v9, s[36:39], s68 offen nt
s_add_u32 s68, s68, s34
buffer_load_dwordx2 v[34:35], v9, s[36:39], s68 offen nt
s_add_u32 s68, s68, s34
buffer_load_dwordx2 v[36:37], v9, s[36:39], s68 offen nt
s_add_u32 s68, s68, s34
buffer_load_dwordx2 v[38:39], v9, s[36:39], s68 offen nt
s_add_u32 s68, s68, s69
buffer_load_dwordx2 v[40:41], v9, s[36:39], s68 offen nt
s_add_u32 s68, s68, s34
buffer_load_dwordx2 v[42:43], v9, s[36:39], s68 offen nt
s_add_u32 s68, s68, s34
buffer_load_dwordx2 v[44:45], v9, s[36:39], s68 offen nt
s_add_u32 s68, s68, s34
buffer_load_dwordx2 v[46:47], v9, s[36:39], s68 offen nt
s_add_u32 s68, s68, s34
buffer_load_dwordx2 v[48:49], v9, s[36:39], s68 offen nt
s_add_u32 s68, s68, s34
buffer_load_dwordx2 v[50:51], v9, s[36:39], s68 offen nt
s_add_u32 s68, s68, s34
buffer_load_dwordx2 v[52:53], v9, s[36:39], s68 offen nt
s_add_u32 s68, s68, s34
buffer_load_dwordx2 v[54:55], v9, s[36:39], s68 offen nt
s_load_dword s32, s[30:31], 0
s_mov_b32 s44, s30
s_mov_b32 s45, s31
s_mov_b32 s46, 268435456
s_mov_b32 s47, 0x20000
s_mov_b32 s96, s30
s_mov_b32 s97, s31
s_mov_b32 s98, 134217728
s_mov_b32 s99, 0x20000
s_add_u32 s96, s30, 8388608
s_addc_u32 s97, s31, 0
s_waitcnt vmcnt(16)
v_lshlrev_b32 v56, 16, v16
v_and_b32 v57, 0xffff0000, v16
v_lshlrev_b32 v58, 16, v17
v_and_b32 v59, 0xffff0000, v17
v_lshlrev_b32 v60, 16, v18
v_and_b32 v61, 0xffff0000, v18
v_lshlrev_b32 v62, 16, v19
v_and_b32 v63, 0xffff0000, v19
v_lshlrev_b32 v64, 16, v20
v_and_b32 v65, 0xffff0000, v20
v_lshlrev_b32 v66, 16, v21
v_and_b32 v67, 0xffff0000, v21
v_lshlrev_b32 v68, 16, v22
v_and_b32 v69, 0xffff0000, v22
v_lshlrev_b32 v70, 16, v23
v_and_b32 v71, 0xffff0000, v23
v_add_f32 v10, v56, v57
v_add_f32 v11, v58, v59
v_add_f32 v10, v10, v60
v_add_f32 v11, v11, v61
v_add_f32 v10, v10, v62
v_add_f32 v11, v11, v63
v_add_f32 v10, v10, v64
v_add_f32 v11, v11, v65
v_add_f32 v10, v10, v66
v_add_f32 v11, v11, v67
v_add_f32 v10, v10, v68
v_add_f32 v11, v11, v69
v_add_f32 v10, v10, v70
v_add_f32 v11, v11, v71
v_add_f32 v10, v10, v11
s_nop 1
v_add_f32_dpp v10, v10, v10 row_ror:8 row_mask:0xf bank_mask:0xf
s_nop 1
v_add_f32_dpp v10, v10, v10 row_ror:4 row_mask:0xf bank_mask:0xf
s_nop 1
v_add_f32_dpp v10, v10, v10 row_ror:2 row_mask:0xf bank_mask:0xf
s_nop 1
v_add_f32_dpp v10, v10, v10 row_ror:1 row_mask:0xf bank_mask:0xf
v_mov_b32 v11, v10
s_nop 1
v_permlane16_swap_b32 v10, v11
v_add_f32 v10, v10, v11
v_mul_f32 v10, 0x3b000000, v10
v_mov_b32 v12, 0
v_mov_b32 v13, 0
v_sub_f32 v14, v56, v10
v_sub_f32 v15, v57, v10
v_fmac_f32 v12, v14, v14
v_fmac_f32 v13, v15, v15
v_sub_f32 v14, v58, v10
v_sub_f32 v15, v59, v10
v_fmac_f32 v12, v14, v14
v_fmac_f32 v13, v15, v15
v_sub_f32 v14, v60, v10
v_sub_f32 v15, v61, v10
v_fmac_f32 v12, v14, v14
v_fmac_f32 v13, v15, v15
v_sub_f32 v14, v62, v10
v_sub_f32 v15, v63, v10
v_fmac_f32 v12, v14, v14
v_fmac_f32 v13, v15, v15
v_sub_f32 v14, v64, v10
v_sub_f32 v15, v65, v10
v_fmac_f32 v12, v14, v14
v_fmac_f32 v13, v15, v15
v_sub_f32 v14, v66, v10
v_sub_f32 v15, v67, v10
v_fmac_f32 v12, v14, v14
v_fmac_f32 v13, v15, v15
v_sub_f32 v14, v68, v10
v_sub_f32 v15, v69, v10
v_fmac_f32 v12, v14, v14
v_fmac_f32 v13, v15, v15
v_sub_f32 v14, v70, v10
v_sub_f32 v15, v71, v10
v_fmac_f32 v12, v14, v14
v_fmac_f32 v13, v15, v15
v_add_f32 v12, v12, v13
s_nop 1
v_add_f32_dpp v12, v12, v12 row_ror:8 row_mask:0xf bank_mask:0xf
s_nop 1
v_add_f32_dpp v12, v12, v12 row_ror:4 row_mask:0xf bank_mask:0xf
s_nop 1
v_add_f32_dpp v12, v12, v12 row_ror:2 row_mask:0xf bank_mask:0xf
s_nop 1
v_add_f32_dpp v12, v12, v12 row_ror:1 row_mask:0xf bank_mask:0xf
v_mov_b32 v13, v12
s_nop 1
v_permlane16_swap_b32 v12, v13
v_add_f32 v12, v12, v13
v_mul_f32 v12, 0x3b000000, v12
v_cvt_pk_bf16_f32 v12, v12, v12
v_and_b32 v12, 0xffff0000, v12
v_cvt_pk_bf16_f32 v10, v10, v10
v_and_b32 v10, 0xffff0000, v10
v_add_f32 v12, 0x3727c5ac, v12
v_cvt_pk_bf16_f32 v12, v12, v12
v_and_b32 v12, 0xffff0000, v12
v_sqrt_f32 v12, v12
s_nop 0
v_cvt_pk_bf16_f32 v12, v12, v12
v_and_b32 v12, 0xffff0000, v12
v_rcp_f32 v12, v12
v_sub_f32 v56, v56, v10
v_sub_f32 v57, v57, v10
v_cvt_pk_bf16_f32 v57, v56, v57
v_lshlrev_b32 v56, 16, v57
v_and_b32 v57, 0xffff0000, v57
v_mul_f32 v56, v56, v12
v_mul_f32 v57, v57, v12
v_cvt_pk_bf16_f32 v16, v56, v57
v_sub_f32 v58, v58, v10
v_sub_f32 v59, v59, v10
v_cvt_pk_bf16_f32 v59, v58, v59
v_lshlrev_b32 v58, 16, v59
v_and_b32 v59, 0xffff0000, v59
v_mul_f32 v58, v58, v12
v_mul_f32 v59, v59, v12
v_cvt_pk_bf16_f32 v17, v58, v59
v_sub_f32 v60, v60, v10
v_sub_f32 v61, v61, v10
v_cvt_pk_bf16_f32 v61, v60, v61
v_lshlrev_b32 v60, 16, v61
v_and_b32 v61, 0xffff0000, v61
v_mul_f32 v60, v60, v12
v_mul_f32 v61, v61, v12
v_cvt_pk_bf16_f32 v18, v60, v61
v_sub_f32 v62, v62, v10
v_sub_f32 v63, v63, v10
v_cvt_pk_bf16_f32 v63, v62, v63
v_lshlrev_b32 v62, 16, v63
v_and_b32 v63, 0xffff0000, v63
v_mul_f32 v62, v62, v12
v_mul_f32 v63, v63, v12
v_cvt_pk_bf16_f32 v19, v62, v63
v_sub_f32 v64, v64, v10
v_sub_f32 v65, v65, v10
v_cvt_pk_bf16_f32 v65, v64, v65
v_lshlrev_b32 v64, 16, v65
v_and_b32 v65, 0xffff0000, v65
v_mul_f32 v64, v64, v12
v_mul_f32 v65, v65, v12
v_cvt_pk_bf16_f32 v20, v64, v65
v_sub_f32 v66, v66, v10
v_sub_f32 v67, v67, v10
v_cvt_pk_bf16_f32 v67, v66, v67
v_lshlrev_b32 v66, 16, v67
v_and_b32 v67, 0xffff0000, v67
v_mul_f32 v66, v66, v12
v_mul_f32 v67, v67, v12
v_cvt_pk_bf16_f32 v21, v66, v67
v_sub_f32 v68, v68, v10
v_sub_f32 v69, v69, v10
v_cvt_pk_bf16_f32 v69, v68, v69
v_lshlrev_b32 v68, 16, v69
v_and_b32 v69, 0xffff0000, v69
v_mul_f32 v68, v68, v12
v_mul_f32 v69, v69, v12
v_cvt_pk_bf16_f32 v22, v68, v69
v_sub_f32 v70, v70, v10
v_sub_f32 v71, v71, v10
v_cvt_pk_bf16_f32 v71, v70, v71
v_lshlrev_b32 v70, 16, v71
v_and_b32 v71, 0xffff0000, v71
v_mul_f32 v70, v70, v12
v_mul_f32 v71, v71, v12
v_cvt_pk_bf16_f32 v23, v70, v71
v_lshrrev_b32 v10, 5, v1
v_lshl_add_u32 v10, v10, 4, v8
s_mul_i32 s60, s3, 2080
v_add_u32 v10, s60, v10
ds_write_b128 v10, v[16:19] offset:2944
ds_write_b128 v10, v[20:23] offset:2960
v_and_b32 v10, 7, v1
v_mul_u32_u24 v10, 1040, v10
v_lshl_add_u32 v10, v7, 4, v10
s_lshl_b32 s60, s63, 7
v_add_u32 v10, s60, v10
s_waitcnt lgkmcnt(0)
v_mov_b32 v11, 0
v_mov_b32 v12, 1
s_mov_b64 exec, 1
ds_add_u32 v11, v12 offset:0
s_mov_b64 exec, -1
L_sync0:
ds_read_b32 v12, v11 offset:0
s_waitcnt lgkmcnt(0)
v_readfirstlane_b32 s60, v12
s_cmp_lt_u32 s60, 4
s_cbranch_scc1 L_sync0
ds_read_b128 v[16:19], v10 offset:2944
ds_read_b128 v[20:23], v10 offset:3008
s_waitcnt vmcnt(8)
v_perm_b32 v56, v26, v24, s64
v_perm_b32 v60, v26, v24, s65
v_perm_b32 v64, v27, v25, s64
v_perm_b32 v68, v27, v25, s65
v_perm_b32 v57, v30, v28, s64
v_perm_b32 v61, v30, v28, s65
v_perm_b32 v65, v31, v29, s64
v_perm_b32 v69, v31, v29, s65
v_perm_b32 v58, v34, v32, s64
v_perm_b32 v62, v34, v32, s65
v_perm_b32 v66, v35, v33, s64
v_perm_b32 v70, v35, v33, s65
v_perm_b32 v59, v38, v36, s64
v_perm_b32 v63, v38, v36, s65
v_perm_b32 v67, v39, v37, s64
v_perm_b32 v71, v39, v37, s65
s_waitcnt lgkmcnt(0)
v_mfma_f32_16x16x32_bf16 v[24:27], v[16:19], v[56:59], 0
v_mfma_f32_16x16x32_bf16 v[28:31], v[16:19], v[60:63], 0
v_mfma_f32_16x16x32_bf16 v[32:35], v[16:19], v[64:67], 0
v_mfma_f32_16x16x32_bf16 v[36:39], v[16:19], v[68:71], 0
s_waitcnt vmcnt(0)
v_perm_b32 v56, v42, v40, s64
v_perm_b32 v60, v42, v40, s65
v_perm_b32 v64, v43, v41, s64
v_perm_b32 v68, v43, v41, s65
v_perm_b32 v57, v46, v44, s64
v_perm_b32 v61, v46, v44, s65
v_perm_b32 v65, v47, v45, s64
v_perm_b32 v69, v47, v45, s65
v_perm_b32 v58, v50, v48, s64
v_perm_b32 v62, v50, v48, s65
v_perm_b32 v66, v51, v49, s64
v_perm_b32 v70, v51, v49, s65
v_perm_b32 v59, v54, v52, s64
v_perm_b32 v63, v54, v52, s65
v_perm_b32 v67, v55, v53, s64
v_perm_b32 v71, v55, v53, s65
v_mfma_f32_16x16x32_bf16 v[24:27], v[20:23], v[56:59], v[24:27]
v_mfma_f32_16x16x32_bf16 v[28:31], v[20:23], v[60:63], v[28:31]
v_mfma_f32_16x16x32_bf16 v[32:35], v[20:23], v[64:67], v[32:35]
v_mfma_f32_16x16x32_bf16 v[36:39], v[20:23], v[68:71], v[36:39]
s_lshl_b32 s60, s3, 11
v_lshl_add_u32 v10, v1, 4, s60
s_mov_b32 exec_hi, 0
s_nop 1
ds_write_b128 v10, v[24:27] offset:11264
ds_write_b128 v10, v[28:31] offset:11776
ds_write_b128 v10, v[32:35] offset:12288
ds_write_b128 v10, v[36:39] offset:12800
s_mov_b32 exec_hi, -1
s_mul_i32 s32, s32, 1664525
s_add_u32 s32, s32, 1013904223
s_lshr_b32 s9, s32, 8
s_lshr_b32 s10, s32, 16
s_lshr_b32 s11, s32, 24
s_mov_b32 s26, 117835008
s_mov_b32 s27, 117835009
s_mov_b32 s28, 117835010
s_mov_b32 s29, 117835011
s_mul_i32 s60, s3, s67
s_lshl_b32 s60, s60, 1
s_add_u32 s66, s66, s60
v_and_b32 v10, 1, v7
v_mul_lo_u32 v10, v10, s67
v_lshl_add_u32 v10, v6, 4, v10
v_mov_b32 v9, s32
s_waitcnt lgkmcnt(0)
v_mov_b32 v11, 0
v_mov_b32 v12, 1
s_mov_b64 exec, 1
ds_add_u32 v11, v12 offset:4
s_mov_b64 exec, -1
L_sync1:
ds_read_b32 v12, v11 offset:4
s_waitcnt lgkmcnt(0)
v_readfirstlane_b32 s60, v12
s_cmp_lt_u32 s60, 4
s_cbranch_scc1 L_sync1
ds_read2st64_b32 v[16:17], v3 offset0:44 offset1:46
ds_read2st64_b32 v[18:19], v3 offset0:48 offset1:50
ds_read2st64_b32 v[20:21], v3 offset0:52 offset1:54
ds_read2st64_b32 v[22:23], v3 offset0:56 offset1:58
s_waitcnt lgkmcnt(0)
v_pk_add_f32 v[16:17], v[16:17], v[20:21]
v_pk_add_f32 v[18:19], v[18:19], v[22:23]
v_mov_b32 v20, v16
v_mov_b32 v21, v17
v_mov_b32 v22, v18
v_mov_b32 v23, v19
v_permlane32_swap_b32 v16, v20
v_permlane32_swap_b32 v17, v21
v_permlane32_swap_b32 v18, v22
v_permlane32_swap_b32 v19, v23
v_pk_add_f32 v[16:17], v[16:17], v[20:21]
v_pk_add_f32 v[18:19], v[18:19], v[22:23]
v_perm_b32 v16, v16, v9, s26
v_perm_b32 v17, v17, v9, s27
v_perm_b32 v18, v18, v9, s28
v_perm_b32 v19, v19, v9, s29
s_mov_b32 exec_hi, 0
s_cmp_ge_u32 s5, 16
s_cbranch_scc1 L_S_nq
buffer_store_dwordx4 v[16:19], v10, s[96:99], s66 offen
L_S_nq:
s_mov_b32 exec_hi, -1
s_branch L_S_gather
L_S_nop1:
s_waitcnt lgkmcnt(0)
s_load_dword s32, s[30:31], 0
s_mov_b32 s44, s30
s_mov_b32 s45, s31
s_mov_b32 s46, 268435456
s_mov_b32 s47, 0x20000
s_mov_b32 s96, s30
s_mov_b32 s97, s31
s_mov_b32 s98, 134217728
s_mov_b32 s99, 0x20000
s_add_u32 s96, s30, 8388608
s_addc_u32 s97, s31, 0
s_barrier
s_waitcnt lgkmcnt(0)
s_mul_i32 s32, s32, 1664525
s_add_u32 s32, s32, 1013904223
s_lshr_b32 s9, s32, 8
s_lshr_b32 s10, s32, 16
s_lshr_b32 s11, s32, 24
s_mov_b32 s26, 117835008
s_mov_b32 s27, 117835009
s_mov_b32 s28, 117835010
s_mov_b32 s29, 117835011
v_mov_b32 v10, 0
s_mov_b32 s66, 0
v_mov_b32 v16, 0
v_mov_b32 v17, 0
v_mov_b32 v18, 0
v_mov_b32 v19, 0
s_sleep 64
L_S_gather:
s_sleep 32
buffer_load_dwordx4 v[20:23], v0, s[96:99], s90 offen nt
s_cmp_ge_u32 s91, 30
s_cbranch_scc1 L_S_ns
s_mov_b32 exec_hi, 0
buffer_store_dwordx4 v[16:19], v10, s[44:47], s66 offen sc1
s_mov_b32 exec_hi, -1
L_S_ns:
v_mov_b32 v14, v0
s_lshr_b32 s34, s5, 3
s_lshl_b32 s60, s4, 2
s_add_u32 s34, s34, s60
s_and_b32 s35, s5, 7
s_lshl_b32 s20, s34, 14
s_lshl_b32 s60, s3, 7
s_add_u32 s20, s20, s60
s_add_u32 s20, s20, 2097152
s_add_u32 s21, s20, 8192
s_lshl_b32 s22, s34, 8
s_add_u32 s22, s22, 3145728
s_lshl_b32 s14, s35, 17
s_lshl_b32 s60, s3, 15
s_add_u32 s14, s14, s60
s_lshl_b32 s60, s34, 9
s_add_u32 s14, s14, s60
s_add_u32 s14, s14, 4194304
v_lshlrev_b32 v0, 9, v6
v_lshl_add_u32 v0, v7, 4, v0
v_and_b32 v4, 4, v6
v_lshlrev_b32 v4, 2, v4
v_and_b32 v8, 3, v6
v_add_u32 v4, v4, v8
v_lshl_add_u32 v4, v7, 2, v4
v_lshlrev_b32 v4, 3, v4
v_lshrrev_b32 v11, 5, v1
v_and_b32 v13, 31, v1
v_lshlrev_b32 v13, 4, v13
v_lshl_add_u32 v8, v11, 14, v13
s_lshl_b32 s60, s3, 4
v_lshl_add_u32 v15, v7, 2, s60
v_and_b32 v9, 7, v6
v_mul_u32_u24 v9, 28672, v9
v_lshrrev_b32 v10, 3, v6
v_mul_u32_u24 v10, 7168, v10
v_add_u32 v9, v9, v10
v_lshl_add_u32 v9, v15, 2, v9
v_lshlrev_b32 v15, 10, v15
v_lshl_add_u32 v15, v6, 3, v15
s_max_u32 s60, s34, 4
s_sub_u32 s60, s60, 4
s_lshl_b32 s12, s60, 8
s_add_u32 s12, s12, 1048576
s_add_u32 s13, s12, 14336
s_lshl_b32 s33, s35, 7
s_lshl_b32 s23, s60, 16
s_add_u32 s23, s23, s33
s_mul_i32 s60, s3, 272
v_lshl_add_u32 v13, v1, 3, s60
s_mov_b32 s48, s16
s_mov_b32 s49, s17
s_mov_b32 s50, 4194304
s_mov_b32 s51, 0x20000
s_mov_b32 s52, s24
s_mov_b32 s53, s25
s_mov_b32 s54, 1835008
s_mov_b32 s55, 0x20000
s_waitcnt vmcnt(1)
s_cmp_lt_u32 s91, 30
s_cbranch_scc1 L_g1d
s_cbranch_execz L_g1d
s_branch L_g1c
L_g1r:
s_mov_b64 exec, vcc
s_sub_u32 s61, s61, 1
s_cmp_lt_i32 s61, 0
s_cbranch_scc1 L_g1k
s_sleep 8
s_and_b32 s60, s61, 7
s_cbranch_scc1 L_g1a
buffer_load_dwordx4 v[20:23], v14, s[44:47], s90 offen sc1
s_branch L_g1c
L_g1a:
buffer_load_dwordx4 v[20:23], v14, s[96:99], s90 offen nt
L_g1c:
s_waitcnt vmcnt(0)
L_g1d:
v_xor_b32 v12, s32, v20
v_bitop3_b32 v12, v12, v21, s9 bitop3:0xf6
v_bitop3_b32 v12, v12, v22, s10 bitop3:0xf6
v_bitop3_b32 v12, v12, v23, s11 bitop3:0xf6
v_and_b32 v12, 0xff, v12
v_cmp_ne_u32 vcc, 0, v12
s_cbranch_vccnz L_g1r
L_g1k:
s_mov_b64 exec, s[92:93]
v_and_b32 v20, 0xffffff00, v20
v_and_b32 v21, 0xffffff00, v21
v_and_b32 v22, 0xffffff00, v22
v_and_b32 v23, 0xffffff00, v23
v_mov_b32 v80, v20
v_mov_b32 v81, v21
v_mov_b32 v82, v22
v_mov_b32 v83, v23
v_permlane32_swap_b32 v80, v20
v_permlane32_swap_b32 v81, v21
v_permlane32_swap_b32 v82, v22
v_permlane32_swap_b32 v83, v23
v_pk_add_f32 v[80:81], v[80:81], v[20:21]
v_pk_add_f32 v[82:83], v[82:83], v[22:23]
v_cvt_pk_bf16_f32 v20, v80, v81
v_cvt_pk_bf16_f32 v21, v82, v83
s_mov_b32 exec_hi, 0
ds_write_b64 v13, v[20:21] offset:512
s_mov_b32 exec_hi, -1
v_mov_b32 v2, 0
v_mov_b32 v12, 1
s_mov_b64 exec, 1
s_waitcnt lgkmcnt(0)
ds_add_u32 v2, v12 offset:8
s_mov_b64 exec, -1
v_lshlrev_b32 v11, 14, v7
v_lshl_add_u32 v11, v6, 3, v11
s_lshl_b32 s66, s34, 17
s_lshl_b32 s60, s3, 11
s_add_u32 s66, s66, s60
s_add_u32 s66, s66, s33
s_add_u32 s67, s66, 8192
s_add_u32 s68, s66, 65536
s_add_u32 s69, s66, 73728
s_getreg_b32 s19, hwreg(HW_REG_XCC_ID, 0, 4)
s_lshl_b32 s18, s4, 8
s_add_u32 s18, s18, 32768
s_cmp_lg_u32 s3, 0
s_cbranch_scc1 L_p1
s_lshl_b32 s60, s5, 3
v_mov_b32 v84, s60
v_mov_b32 v86, s19
v_mov_b32 v87, s32
s_mov_b64 exec, 1
buffer_store_dwordx2 v[86:87], v84, s[44:47], s18 offen
s_mov_b64 exec, -1
L_p1:
L_vw:
ds_read_b32 v12, v2 offset:12
s_waitcnt lgkmcnt(0)
v_readfirstlane_b32 s60, v12
s_cmp_ge_u32 s60, 8
s_cbranch_scc1 L_vk
s_sleep 1
s_branch L_vw
L_vk:
s_cmp_eq_u32 s4, 0
s_cbranch_scc1 L_x0
buffer_load_dwordx4 v[80:83], v9, s[44:47], s12 offen
buffer_load_dwordx4 v[84:87], v9, s[44:47], s13 offen
buffer_load_dwordx2 v[40:41], v15, s[52:55], s23 offen offset:0 nt
buffer_load_dwordx2 v[42:43], v15, s[52:55], s23 offen offset:1024 nt
buffer_load_dwordx2 v[44:45], v15, s[52:55], s23 offen offset:2048 nt
buffer_load_dwordx2 v[46:47], v15, s[52:55], s23 offen offset:3072 nt
L_x0:
buffer_load_dwordx2 v[24:25], v11, s[48:51], s66 offen offset:0 nt
buffer_load_dwordx2 v[26:27], v11, s[48:51], s66 offen offset:1024 nt
buffer_load_dwordx2 v[28:29], v11, s[48:51], s67 offen offset:0 nt
buffer_load_dwordx2 v[30:31], v11, s[48:51], s67 offen offset:1024 nt
buffer_load_dwordx2 v[32:33], v11, s[48:51], s68 offen offset:0 nt
buffer_load_dwordx2 v[34:35], v11, s[48:51], s68 offen offset:1024 nt
buffer_load_dwordx2 v[36:37], v11, s[48:51], s69 offen offset:0 nt
buffer_load_dwordx2 v[38:39], v11, s[48:51], s69 offen offset:1024 nt
s_lshl_b32 s60, s3, 11
v_lshl_add_u32 v10, v1, 4, s60
s_cmp_lg_u32 s4, 0
s_cbranch_scc1 L_x1
v_mov_b32 v80, 0
v_mov_b32 v81, 0
v_mov_b32 v82, 0
v_mov_b32 v83, 0
v_mov_b32 v84, 0
v_mov_b32 v85, 0
v_mov_b32 v86, 0
v_mov_b32 v87, 0
v_mov_b32 v88, 0
v_mov_b32 v89, 0
v_mov_b32 v90, 0
v_mov_b32 v91, 0
v_mov_b32 v92, 0
v_mov_b32 v93, 0
v_mov_b32 v94, 0
v_mov_b32 v95, 0
s_branch L_x2
L_x1:
s_cbranch_execz L_g5d
s_waitcnt vmcnt(8)
s_branch L_g5d
s_cbranch_execz L_g5d
s_branch L_g5c
L_g5r:
s_mov_b64 exec, vcc
s_sub_u32 s61, s61, 1
s_cmp_lt_i32 s61, 0
s_cbranch_scc1 L_g5k
s_sleep 8
buffer_load_dwordx4 v[80:83], v9, s[44:47], s12 offen sc1
buffer_load_dwordx4 v[84:87], v9, s[44:47], s13 offen sc1
L_g5c:
s_waitcnt vmcnt(0)
L_g5d:
v_xor_b32 v12, s32, v80
v_bitop3_b32 v12, v12, v81, s9 bitop3:0xf6
v_bitop3_b32 v12, v12, v82, s10 bitop3:0xf6
v_bitop3_b32 v12, v12, v83, s11 bitop3:0xf6
v_bitop3_b32 v12, v12, v84, s32 bitop3:0xf6
v_bitop3_b32 v12, v12, v85, s9 bitop3:0xf6
v_bitop3_b32 v12, v12, v86, s10 bitop3:0xf6
v_bitop3_b32 v12, v12, v87, s11 bitop3:0xf6
v_and_b32 v12, 0xff, v12
v_cmp_ne_u32 vcc, 0, v12
s_cbranch_vccnz L_g5r
L_g5k:
s_mov_b64 exec, s[92:93]
v_and_b32 v80, 0xffffff00, v80
v_and_b32 v81, 0xffffff00, v81
v_and_b32 v82, 0xffffff00, v82
v_and_b32 v83, 0xffffff00, v83
v_and_b32 v84, 0xffffff00, v84
v_and_b32 v85, 0xffffff00, v85
v_and_b32 v86, 0xffffff00, v86
v_and_b32 v87, 0xffffff00, v87
v_add_f32_dpp v80, v80, v80 row_ror:8 row_mask:0xf bank_mask:0xf
v_add_f32_dpp v81, v81, v81 row_ror:8 row_mask:0xf bank_mask:0xf
v_add_f32_dpp v82, v82, v82 row_ror:8 row_mask:0xf bank_mask:0xf
v_add_f32_dpp v83, v83, v83 row_ror:8 row_mask:0xf bank_mask:0xf
v_add_f32_dpp v84, v84, v84 row_ror:8 row_mask:0xf bank_mask:0xf
v_add_f32_dpp v85, v85, v85 row_ror:8 row_mask:0xf bank_mask:0xf
v_add_f32_dpp v86, v86, v86 row_ror:8 row_mask:0xf bank_mask:0xf
v_add_f32_dpp v87, v87, v87 row_ror:8 row_mask:0xf bank_mask:0xf
v_max_f32 v80, 0, v80
v_max_f32 v81, 0, v81
v_cvt_pk_bf16_f32 v80, v80, v81
v_cvt_pk_bf16_f32 v84, v84, v85
v_and_b32 v81, 0xffff0000, v80
v_lshlrev_b32 v80, 16, v80
v_and_b32 v85, 0xffff0000, v84
v_lshlrev_b32 v84, 16, v84
v_mul_f32 v80, v80, v84
v_mul_f32 v81, v81, v85
v_cvt_pk_bf16_f32 v12, v80, v81
v_max_f32 v82, 0, v82
v_max_f32 v83, 0, v83
v_cvt_pk_bf16_f32 v82, v82, v83
v_cvt_pk_bf16_f32 v86, v86, v87
v_and_b32 v83, 0xffff0000, v82
v_lshlrev_b32 v82, 16, v82
v_and_b32 v87, 0xffff0000, v86
v_lshlrev_b32 v86, 16, v86
v_mul_f32 v82, v82, v86
v_mul_f32 v83, v83, v87
v_cvt_pk_bf16_f32 v13, v82, v83
v_perm_b32 v48, v42, v40, s64
v_perm_b32 v50, v42, v40, s65
v_perm_b32 v52, v43, v41, s64
v_perm_b32 v54, v43, v41, s65
v_perm_b32 v49, v46, v44, s64
v_perm_b32 v51, v46, v44, s65
v_perm_b32 v53, v47, v45, s64
v_perm_b32 v55, v47, v45, s65
v_mfma_f32_16x16x16_bf16 v[80:83], v[12:13], v[48:49], 0
v_mfma_f32_16x16x16_bf16 v[84:87], v[12:13], v[50:51], 0
v_mfma_f32_16x16x16_bf16 v[88:91], v[12:13], v[52:53], 0
v_mfma_f32_16x16x16_bf16 v[92:95], v[12:13], v[54:55], 0
s_nop 7
s_nop 3
L_x2:
s_mov_b32 exec_hi, 0
ds_write_b128 v10, v[80:83] offset:11264
ds_write_b128 v10, v[84:87] offset:11776
ds_write_b128 v10, v[88:91] offset:12288
ds_write_b128 v10, v[92:95] offset:12800
s_mov_b64 exec, s[92:93]
s_lshl_b32 s60, s3, 9
v_lshl_add_u32 v11, v1, 3, s60
s_waitcnt vmcnt(0)
v_perm_b32 v56, v26, v24, s64
v_perm_b32 v60, v26, v24, s65
v_perm_b32 v64, v27, v25, s64
v_perm_b32 v68, v27, v25, s65
v_perm_b32 v57, v30, v28, s64
v_perm_b32 v61, v30, v28, s65
v_perm_b32 v65, v31, v29, s64
v_perm_b32 v69, v31, v29, s65
v_perm_b32 v58, v34, v32, s64
v_perm_b32 v62, v34, v32, s65
v_perm_b32 v66, v35, v33, s64
v_perm_b32 v70, v35, v33, s65
v_perm_b32 v59, v38, v36, s64
v_perm_b32 v63, v38, v36, s65
v_perm_b32 v67, v39, v37, s64
v_perm_b32 v71, v39, v37, s65
L_zw:
ds_read_b32 v12, v2 offset:16
s_waitcnt lgkmcnt(0)
v_readfirstlane_b32 s60, v12
s_cmp_ge_u32 s60, 8
s_cbranch_scc1 L_zk
s_sleep 1
s_branch L_zw
L_zk:
buffer_load_dwordx4 v[16:19], v0, s[96:99], s20 offen offset:0 nt
buffer_load_dwordx4 v[20:23], v0, s[96:99], s20 offen offset:64 nt
buffer_load_dwordx4 v[72:75], v0, s[96:99], s21 offen offset:0 nt
buffer_load_dwordx4 v[76:79], v0, s[96:99], s21 offen offset:64 nt
buffer_load_dwordx2 v[2:3], v4, s[96:99], s22 offen nt
v_mov_b32 v12, s32
s_cbranch_execz L_g4d
s_branch L_g4c
L_g4r:
s_mov_b64 exec, vcc
s_sub_u32 s61, s61, 1
s_cmp_lt_i32 s61, 0
s_cbranch_scc1 L_g4k
s_sleep 2
s_and_b32 s60, s61, 15
s_cbranch_scc1 L_g4a
buffer_load_dwordx4 v[16:19], v0, s[44:47], s20 offen offset:0 sc1
buffer_load_dwordx4 v[20:23], v0, s[44:47], s20 offen offset:64 sc1
buffer_load_dwordx4 v[72:75], v0, s[44:47], s21 offen offset:0 sc1
buffer_load_dwordx4 v[76:79], v0, s[44:47], s21 offen offset:64 sc1
buffer_load_dwordx2 v[2:3], v4, s[44:47], s22 offen sc1
s_branch L_g4c
L_g4a:
buffer_load_dwordx4 v[16:19], v0, s[96:99], s20 offen offset:0 nt
buffer_load_dwordx4 v[20:23], v0, s[96:99], s20 offen offset:64 nt
buffer_load_dwordx4 v[72:75], v0, s[96:99], s21 offen offset:0 nt
buffer_load_dwordx4 v[76:79], v0, s[96:99], s21 offen offset:64 nt
buffer_load_dwordx2 v[2:3], v4, s[96:99], s22 offen nt
L_g4c:
s_waitcnt vmcnt(0)
L_g4d:
v_xor_b32 v9, s32, v17
v_bitop3_b32 v9, v9, v19, s32 bitop3:0xf6
v_bitop3_b32 v9, v9, v21, s32 bitop3:0xf6
v_bitop3_b32 v9, v9, v23, s32 bitop3:0xf6
v_bitop3_b32 v9, v9, v73, s32 bitop3:0xf6
v_bitop3_b32 v9, v9, v75, s32 bitop3:0xf6
v_bitop3_b32 v9, v9, v77, s32 bitop3:0xf6
v_bitop3_b32 v9, v9, v79, s32 bitop3:0xf6
v_bitop3_b32 v9, v9, v3, s32 bitop3:0xf6
v_cmp_ne_u32 vcc, 0, v9
s_cbranch_vccnz L_g4r
L_g4k:
s_mov_b64 exec, s[92:93]
v_mov_b32 v17, v18
v_mov_b32 v18, v20
v_mov_b32 v19, v22
v_mov_b32 v73, v74
v_mov_b32 v74, v76
v_mov_b32 v75, v78
s_cbranch_execz L_m1
v_mfma_f32_16x16x32_bf16 v[24:27], v[16:19], v[56:59], 0
v_mfma_f32_16x16x32_bf16 v[28:31], v[16:19], v[60:63], 0
v_mfma_f32_16x16x32_bf16 v[32:35], v[16:19], v[64:67], 0
v_mfma_f32_16x16x32_bf16 v[36:39], v[16:19], v[68:71], 0
v_mfma_f32_16x16x32_bf16 v[40:43], v[72:75], v[56:59], 0
v_mfma_f32_16x16x32_bf16 v[44:47], v[72:75], v[60:63], 0
v_mfma_f32_16x16x32_bf16 v[48:51], v[72:75], v[64:67], 0
v_mfma_f32_16x16x32_bf16 v[52:55], v[72:75], v[68:71], 0
L_m1:
v_max_f32_dpp v9, v2, v2 quad_perm:[1,0,3,2] row_mask:0xf bank_mask:0xf
s_nop 1
v_max_f32_dpp v9, v9, v9 quad_perm:[2,3,0,1] row_mask:0xf bank_mask:0xf
v_sub_f32 v2, v2, v9
v_exp_f32 v2, v2
s_nop 1
v_add_f32_dpp v9, v2, v2 quad_perm:[1,0,3,2] row_mask:0xf bank_mask:0xf
s_nop 1
v_add_f32_dpp v9, v9, v9 quad_perm:[2,3,0,1] row_mask:0xf bank_mask:0xf
v_rcp_f32 v9, v9
s_nop 0
v_mul_f32 v2, v2, v9
s_nop 1
v_mul_f32_dpp v20, v2, v24 row_newbcast:0 row_mask:0xf bank_mask:0xf
v_mul_f32_dpp v21, v2, v28 row_newbcast:0 row_mask:0xf bank_mask:0xf
v_mul_f32_dpp v22, v2, v32 row_newbcast:0 row_mask:0xf bank_mask:0xf
v_mul_f32_dpp v23, v2, v36 row_newbcast:0 row_mask:0xf bank_mask:0xf
v_fmac_f32_dpp v20, v2, v25 row_newbcast:1 row_mask:0xf bank_mask:0xf
v_fmac_f32_dpp v21, v2, v29 row_newbcast:1 row_mask:0xf bank_mask:0xf
v_fmac_f32_dpp v22, v2, v33 row_newbcast:1 row_mask:0xf bank_mask:0xf
v_fmac_f32_dpp v23, v2, v37 row_newbcast:1 row_mask:0xf bank_mask:0xf
v_fmac_f32_dpp v20, v2, v26 row_newbcast:2 row_mask:0xf bank_mask:0xf
v_fmac_f32_dpp v21, v2, v30 row_newbcast:2 row_mask:0xf bank_mask:0xf
v_fmac_f32_dpp v22, v2, v34 row_newbcast:2 row_mask:0xf bank_mask:0xf
v_fmac_f32_dpp v23, v2, v38 row_newbcast:2 row_mask:0xf bank_mask:0xf
v_fmac_f32_dpp v20, v2, v27 row_newbcast:3 row_mask:0xf bank_mask:0xf
v_fmac_f32_dpp v21, v2, v31 row_newbcast:3 row_mask:0xf bank_mask:0xf
v_fmac_f32_dpp v22, v2, v35 row_newbcast:3 row_mask:0xf bank_mask:0xf
v_fmac_f32_dpp v23, v2, v39 row_newbcast:3 row_mask:0xf bank_mask:0xf
ds_write_b128 v10, v[20:23] offset:35840
v_mul_f32_dpp v76, v2, v40 row_newbcast:4 row_mask:0xf bank_mask:0xf
v_mul_f32_dpp v77, v2, v44 row_newbcast:4 row_mask:0xf bank_mask:0xf
v_mul_f32_dpp v78, v2, v48 row_newbcast:4 row_mask:0xf bank_mask:0xf
v_mul_f32_dpp v79, v2, v52 row_newbcast:4 row_mask:0xf bank_mask:0xf
v_fmac_f32_dpp v76, v2, v41 row_newbcast:5 row_mask:0xf bank_mask:0xf
v_fmac_f32_dpp v77, v2, v45 row_newbcast:5 row_mask:0xf bank_mask:0xf
v_fmac_f32_dpp v78, v2, v49 row_newbcast:5 row_mask:0xf bank_mask:0xf
v_fmac_f32_dpp v79, v2, v53 row_newbcast:5 row_mask:0xf bank_mask:0xf
v_fmac_f32_dpp v76, v2, v42 row_newbcast:6 row_mask:0xf bank_mask:0xf
v_fmac_f32_dpp v77, v2, v46 row_newbcast:6 row_mask:0xf bank_mask:0xf
v_fmac_f32_dpp v78, v2, v50 row_newbcast:6 row_mask:0xf bank_mask:0xf
v_fmac_f32_dpp v79, v2, v54 row_newbcast:6 row_mask:0xf bank_mask:0xf
v_fmac_f32_dpp v76, v2, v43 row_newbcast:7 row_mask:0xf bank_mask:0xf
v_fmac_f32_dpp v77, v2, v47 row_newbcast:7 row_mask:0xf bank_mask:0xf
v_fmac_f32_dpp v78, v2, v51 row_newbcast:7 row_mask:0xf bank_mask:0xf
v_fmac_f32_dpp v79, v2, v55 row_newbcast:7 row_mask:0xf bank_mask:0xf
ds_write_b128 v10, v[76:79] offset:36864
s_waitcnt lgkmcnt(0)
s_cbranch_execz L_t2
s_barrier
L_t2:
ds_read_b64 v[16:17], v11 offset:35840
ds_read_b64 v[20:21], v11 offset:37888
ds_read_b64 v[24:25], v11 offset:39936
ds_read_b64 v[28:29], v11 offset:41984
ds_read2st64_b32 v[18:19], v5 offset0:44 offset1:46
ds_read2st64_b32 v[22:23], v5 offset0:52 offset1:54
ds_read2st64_b32 v[26:27], v5 offset0:60 offset1:62
ds_read2st64_b32 v[30:31], v5 offset0:68 offset1:70
s_waitcnt lgkmcnt(4)
v_pk_add_f32 v[16:17], v[16:17], v[20:21]
v_pk_add_f32 v[24:25], v[24:25], v[28:29]
s_waitcnt lgkmcnt(0)
v_pk_add_f32 v[18:19], v[18:19], v[22:23]
v_pk_add_f32 v[26:27], v[26:27], v[30:31]
v_pk_add_f32 v[16:17], v[16:17], v[24:25]
v_pk_add_f32 v[18:19], v[18:19], v[26:27]
v_perm_b32 v16, v16, v12, s26
v_perm_b32 v17, v17, v12, s27
v_perm_b32 v18, v18, v12, s28
v_perm_b32 v19, v19, v12, s29
buffer_store_dwordx4 v[16:19], v8, s[44:47], s14 offen sc1
s_endpgm
L_A:
s_sub_u32 s3, s3, 4
s_setprio 1
s_lshl_b32 s33, s6, 23
s_lshl_b32 s60, s4, 20
s_add_u32 s33, s33, s60
s_lshl_b32 s60, s7, 16
s_add_u32 s33, s33, s60
s_lshl_b32 s60, s3, 13
s_add_u32 s33, s33, s60
s_add_u32 s33, s33, 0xc0000
s_add_u32 s34, s33, 4096
v_lshlrev_b32 v2, 8, v6
v_lshl_add_u32 v2, v7, 4, v2
v_lshlrev_b32 v3, 10, v7
v_lshl_add_u32 v3, v6, 4, v3
s_waitcnt lgkmcnt(0)
s_mov_b32 s36, s10
s_mov_b32 s37, s11
s_mov_b32 s38, 67108864
s_mov_b32 s39, 0x20000
s_mov_b32 s40, s12
s_mov_b32 s41, s13
s_mov_b32 s42, 67108864
s_mov_b32 s43, 0x20000
s_mov_b32 s44, s30
s_mov_b32 s45, s31
s_mov_b32 s46, 268435456
s_mov_b32 s47, 0x20000
s_mov_b32 s48, s8
s_mov_b32 s49, s9
s_mov_b32 s50, 8192
s_mov_b32 s51, 0x20000
s_mov_b32 s56, s26
s_mov_b32 s57, s27
s_mov_b32 s58, 8192
s_mov_b32 s59, 0x20000
s_lshl_b32 s18, s4, 8
s_add_u32 s18, s18, 32768
v_and_b32 v82, 31, v1
v_lshlrev_b32 v82, 3, v82
s_barrier
s_load_dword s32, s[30:31], 0
buffer_load_dwordx4 v[16:19], v2, s[36:39], s33 offen offset:0 nt
buffer_load_dwordx4 v[20:23], v2, s[36:39], s33 offen offset:64 nt
buffer_load_dwordx4 v[24:27], v2, s[36:39], s33 offen offset:128 nt
buffer_load_dwordx4 v[28:31], v2, s[36:39], s33 offen offset:192 nt
buffer_load_dwordx4 v[32:35], v2, s[36:39], s34 offen offset:0 nt
buffer_load_dwordx4 v[36:39], v2, s[36:39], s34 offen offset:64 nt
buffer_load_dwordx4 v[40:43], v2, s[36:39], s34 offen offset:128 nt
buffer_load_dwordx4 v[44:47], v2, s[36:39], s34 offen offset:192 nt
s_lshl_b32 s60, s4, 2
s_add_u32 s60, s60, s3
s_lshl_b32 s20, s60, 14
s_lshl_b32 s21, s5, 9
s_add_u32 s20, s20, s21
s_add_u32 s20, s20, 2097152
s_lshl_b32 s21, s60, 8
s_lshl_b32 s60, s5, 3
s_add_u32 s21, s21, s60
s_add_u32 s21, s21, 3145728
s_add_u32 s23, s20, 8388608
s_add_u32 s24, s21, 8388608
s_lshl_b32 s22, s6, 10
s_lshl_b32 s60, s4, 7
s_add_u32 s22, s22, s60
s_lshl_b32 s60, s7, 5
s_add_u32 s22, s22, s60
s_lshl_b32 s84, s4, 17
s_lshl_b32 s60, s6, 14
s_add_u32 s84, s84, s60
s_lshl_b32 s60, s7, 7
s_add_u32 s84, s84, s60
s_add_u32 s84, s84, 4194304
s_add_u32 s85, s84, 4096
s_add_u32 s86, s84, 8192
s_add_u32 s87, s84, 12288
v_and_b32 v85, 7, v1
v_lshlrev_b32 v84, 4, v85
v_lshlrev_b32 v85, 2, v85
v_lshrrev_b32 v86, 3, v1
v_lshl_add_u32 v84, v86, 9, v84
v_mov_b32 v87, 1
v_and_b32 v0, 3, v1
v_mul_u32_u24 v2, 272, v0
v_lshl_add_u32 v2, v7, 4, v2
v_lshlrev_b32 v0, 5, v0
s_mov_b32 s62, 1035273459
s_mov_b32 s63, 1069066811
s_lshl_b32 s60, s3, 2
v_add_u32 v88, s60, v0
v_mov_b32 v83, 0
s_getreg_b32 s19, hwreg(HW_REG_XCC_ID, 0, 4)
s_lshl_b32 s60, s3, 11
v_lshl_add_u32 v89, v1, 3, s60
v_add_u32 v89, 19456, v89
v_add_u32 v90, 1024, v89
s_lshl_b32 s60, s3, 9
v_lshl_add_u32 v91, v1, 3, s60
s_lshl_b32 s60, s3, 5
v_mov_b32 v92, s60
v_lshlrev_b32 v93, 3, v1
s_waitcnt lgkmcnt(0)
s_mul_i32 s32, s32, 1664525
s_add_u32 s32, s32, 1013904223
s_lshr_b32 s9, s32, 8
s_lshr_b32 s10, s32, 16
s_lshr_b32 s11, s32, 24
s_setprio 0
buffer_load_dwordx4 v[48:51], v3, s[40:43], s33 offen offset:0 nt
buffer_load_dwordx4 v[52:55], v3, s[40:43], s33 offen offset:256 nt
buffer_load_dwordx4 v[56:59], v3, s[40:43], s33 offen offset:512 nt
buffer_load_dwordx4 v[60:63], v3, s[40:43], s33 offen offset:768 nt
buffer_load_dwordx4 v[64:67], v3, s[40:43], s34 offen offset:0 nt
buffer_load_dwordx4 v[68:71], v3, s[40:43], s34 offen offset:256 nt
buffer_load_dwordx4 v[72:75], v3, s[40:43], s34 offen offset:512 nt
buffer_load_dwordx4 v[76:79], v3, s[40:43], s34 offen offset:768 nt
buffer_load_dwordx2 v[80:81], v82, s[44:47], s18 offen
s_mov_b64 exec, 1
ds_add_u32 v83, v87 offset:12
s_mov_b64 exec, -1
s_setprio 2
L_A_back:
s_mov_b64 s[92:93], -1
s_mov_b64 exec, -1
L_qw:
ds_read_b32 v4, v83 offset:8
s_waitcnt lgkmcnt(0)
v_readfirstlane_b32 s60, v4
s_cmp_lt_u32 s60, 4
s_cbranch_scc1 L_qw
L_qk:
ds_read_b128 v[96:99], v2 offset:512
ds_read_b128 v[100:103], v2 offset:576
ds_read_b128 v[104:107], v2 offset:640
ds_read_b128 v[108:111], v2 offset:704
s_waitcnt vmcnt(9)
L_A_dry:
s_waitcnt lgkmcnt(3)
v_mfma_f32_16x16x32_bf16 v[8:11], v[16:19], v[96:99], 0
v_mfma_f32_16x16x32_bf16 v[12:15], v[32:35], v[96:99], 0
s_waitcnt lgkmcnt(2)
v_mfma_f32_16x16x32_bf16 v[8:11], v[20:23], v[100:103], v[8:11]
v_mfma_f32_16x16x32_bf16 v[12:15], v[36:39], v[100:103], v[12:15]
s_waitcnt lgkmcnt(1)
v_mfma_f32_16x16x32_bf16 v[8:11], v[24:27], v[104:107], v[8:11]
v_mfma_f32_16x16x32_bf16 v[12:15], v[40:43], v[104:107], v[12:15]
s_waitcnt lgkmcnt(0)
v_mfma_f32_16x16x32_bf16 v[8:11], v[28:31], v[108:111], v[8:11]
v_mfma_f32_16x16x32_bf16 v[12:15], v[44:47], v[108:111], v[12:15]
s_nop 6
v_cvt_pk_bf16_f32 v9, v8, v9
v_cvt_pk_bf16_f32 v11, v10, v11
v_cvt_pk_bf16_f32 v13, v12, v13
v_cvt_pk_bf16_f32 v15, v14, v15
v_lshlrev_b32 v8, 16, v9
v_and_b32 v9, 0xffff0000, v9
v_lshlrev_b32 v10, 16, v11
v_and_b32 v11, 0xffff0000, v11
v_lshlrev_b32 v12, 16, v13
v_and_b32 v13, 0xffff0000, v13
v_lshlrev_b32 v14, 16, v15
v_and_b32 v15, 0xffff0000, v15
v_pk_mul_f32 v[8:9], v[8:9], s[62:63] op_sel_hi:[1,0]
v_pk_mul_f32 v[10:11], v[10:11], s[62:63] op_sel_hi:[1,0]
v_pk_mul_f32 v[12:13], v[12:13], s[62:63] op_sel_hi:[1,0]
v_pk_mul_f32 v[14:15], v[14:15], s[62:63] op_sel_hi:[1,0]
v_cvt_pk_bf16_f32 v9, v8, v9
v_cvt_pk_bf16_f32 v11, v10, v11
v_cvt_pk_bf16_f32 v13, v12, v13
v_cvt_pk_bf16_f32 v15, v14, v15
v_lshlrev_b32 v8, 16, v9
v_and_b32 v9, 0xffff0000, v9
v_lshlrev_b32 v10, 16, v11
v_and_b32 v11, 0xffff0000, v11
v_lshlrev_b32 v12, 16, v13
v_and_b32 v13, 0xffff0000, v13
v_lshlrev_b32 v14, 16, v15
v_and_b32 v15, 0xffff0000, v15
v_max3_f32 v4, v8, v9, v10
v_max3_f32 v5, v11, v12, v13
v_max3_f32 v4, v4, v14, v15
v_max_f32 v4, v4, v5
v_mov_b32 v5, v4
s_nop 1
v_permlane16_swap_b32 v4, v5
v_max_f32 v4, v4, v5
v_mov_b32 v5, v4
s_nop 1
v_permlane32_swap_b32 v4, v5
v_max_f32 v4, v4, v5
v_mul_f32 v0, s63, v4
v_fma_f32 v8, v8, s63, -v0
v_fma_f32 v9, v9, s63, -v0
v_fma_f32 v10, v10, s63, -v0
v_fma_f32 v11, v11, s63, -v0
v_fma_f32 v12, v12, s63, -v0
v_fma_f32 v13, v13, s63, -v0
v_fma_f32 v14, v14, s63, -v0
v_fma_f32 v15, v15, s63, -v0
v_exp_f32 v8, v8
v_exp_f32 v9, v9
v_exp_f32 v10, v10
v_exp_f32 v11, v11
v_exp_f32 v12, v12
v_exp_f32 v13, v13
v_exp_f32 v14, v14
v_exp_f32 v15, v15
v_cvt_pk_bf16_f32 v32, v8, v9
v_cvt_pk_bf16_f32 v33, v10, v11
v_cvt_pk_bf16_f32 v34, v12, v13
v_cvt_pk_bf16_f32 v35, v14, v15
v_pk_add_f32 v[4:5], v[8:9], v[10:11]
v_pk_add_f32 v[6:7], v[12:13], v[14:15]
v_pk_add_f32 v[4:5], v[4:5], v[6:7]
v_add_f32 v4, v4, v5
s_mov_b32 s66, 983055
s_mov_b32 s67, 983055
v_cndmask_b32 v16, 0, v32, s[66:67]
v_cndmask_b32 v17, 0, v33, s[66:67]
v_cndmask_b32 v18, 0, v34, s[66:67]
v_cndmask_b32 v19, 0, v35, s[66:67]
s_mov_b32 s66, 15728880
s_mov_b32 s67, 15728880
v_cndmask_b32 v20, 0, v32, s[66:67]
v_cndmask_b32 v21, 0, v33, s[66:67]
v_cndmask_b32 v22, 0, v34, s[66:67]
v_cndmask_b32 v23, 0, v35, s[66:67]
s_mov_b32 s66, 251662080
s_mov_b32 s67, 251662080
v_cndmask_b32 v24, 0, v32, s[66:67]
v_cndmask_b32 v25, 0, v33, s[66:67]
v_cndmask_b32 v26, 0, v34, s[66:67]
v_cndmask_b32 v27, 0, v35, s[66:67]
s_mov_b32 s66, 4026593280
s_mov_b32 s67, 4026593280
v_cndmask_b32 v28, 0, v32, s[66:67]
v_cndmask_b32 v29, 0, v33, s[66:67]
v_cndmask_b32 v30, 0, v34, s[66:67]
v_cndmask_b32 v31, 0, v35, s[66:67]
v_mov_b32 v5, v4
s_nop 1
v_permlane16_swap_b32 v4, v5
v_add_f32 v4, v4, v5
v_mov_b32 v5, v4
s_nop 1
v_permlane32_swap_b32 v4, v5
v_add_f32 v4, v4, v5
s_and_b64 exec, s[92:93], 15
ds_write_b32 v88, v0 offset:128
ds_write_b32 v88, v4 offset:256
s_mov_b64 exec, s[92:93]
s_mov_b64 exec, 1
ds_add_u32 v83, v87 offset:20
s_mov_b64 exec, -1
s_waitcnt vmcnt(7)
v_perm_b32 v32, v52, v48, s64
v_perm_b32 v34, v52, v48, s65
v_perm_b32 v36, v53, v49, s64
v_perm_b32 v38, v53, v49, s65
v_perm_b32 v40, v54, v50, s64
v_perm_b32 v42, v54, v50, s65
v_perm_b32 v44, v55, v51, s64
v_perm_b32 v46, v55, v51, s65
s_waitcnt vmcnt(5)
v_perm_b32 v33, v60, v56, s64
v_perm_b32 v35, v60, v56, s65
v_perm_b32 v37, v61, v57, s64
v_perm_b32 v39, v61, v57, s65
v_perm_b32 v41, v62, v58, s64
v_perm_b32 v43, v62, v58, s65
v_perm_b32 v45, v63, v59, s64
v_perm_b32 v47, v63, v59, s65
v_mfma_f32_16x16x16_bf16 v[8:11], v[16:17], v[32:33], 0
v_mfma_f32_16x16x16_bf16 v[12:15], v[16:17], v[34:35], 0
v_mfma_f32_16x16x16_bf16 v[8:11], v[20:21], v[36:37], v[8:11]
v_mfma_f32_16x16x16_bf16 v[12:15], v[20:21], v[38:39], v[12:15]
v_mfma_f32_16x16x16_bf16 v[8:11], v[24:25], v[40:41], v[8:11]
v_mfma_f32_16x16x16_bf16 v[12:15], v[24:25], v[42:43], v[12:15]
v_mfma_f32_16x16x16_bf16 v[8:11], v[28:29], v[44:45], v[8:11]
v_mfma_f32_16x16x16_bf16 v[12:15], v[28:29], v[46:47], v[12:15]
s_waitcnt vmcnt(3)
v_perm_b32 v32, v68, v64, s64
v_perm_b32 v34, v68, v64, s65
v_perm_b32 v36, v69, v65, s64
v_perm_b32 v38, v69, v65, s65
v_perm_b32 v40, v70, v66, s64
v_perm_b32 v42, v70, v66, s65
v_perm_b32 v44, v71, v67, s64
v_perm_b32 v46, v71, v67, s65
s_waitcnt vmcnt(1)
v_perm_b32 v33, v76, v72, s64
v_perm_b32 v35, v76, v72, s65
v_perm_b32 v37, v77, v73, s64
v_perm_b32 v39, v77, v73, s65
v_perm_b32 v41, v78, v74, s64
v_perm_b32 v43, v78, v74, s65
v_perm_b32 v45, v79, v75, s64
v_perm_b32 v47, v79, v75, s65
v_mfma_f32_16x16x16_bf16 v[8:11], v[18:19], v[32:33], v[8:11]
v_mfma_f32_16x16x16_bf16 v[12:15], v[18:19], v[34:35], v[12:15]
v_mfma_f32_16x16x16_bf16 v[8:11], v[22:23], v[36:37], v[8:11]
v_mfma_f32_16x16x16_bf16 v[12:15], v[22:23], v[38:39], v[12:15]
v_mfma_f32_16x16x16_bf16 v[8:11], v[26:27], v[40:41], v[8:11]
v_mfma_f32_16x16x16_bf16 v[12:15], v[26:27], v[42:43], v[12:15]
v_mfma_f32_16x16x16_bf16 v[8:11], v[30:31], v[44:45], v[8:11]
v_mfma_f32_16x16x16_bf16 v[12:15], v[30:31], v[46:47], v[12:15]
s_nop 7
ds_write2_b32 v89, v8, v12 offset0:0 offset1:1
ds_write2_b32 v89, v9, v13 offset0:128 offset1:129
ds_write2_b32 v90, v10, v14 offset0:0 offset1:1
ds_write2_b32 v90, v11, v15 offset0:128 offset1:129
s_waitcnt lgkmcnt(0)
s_and_b64 exec, s[92:93], 1
ds_add_u32 v83, v87 offset:16
s_mov_b64 exec, s[92:93]
L_A_tail:
s_cmp_ge_u32 s3, 4
s_cbranch_scc1 L_A_hi
s_waitcnt vmcnt(0)
v_cmp_ne_u32 vcc, s19, v80
v_cmp_ne_u32 s[62:63], s32, v81
s_or_b64 s[62:63], vcc, s[62:63]
L_sw:
ds_read_b32 v4, v83 offset:20
ds_read_b128 v[48:51], v92 offset:128
ds_read_b128 v[52:55], v92 offset:144
ds_read_b128 v[32:35], v92 offset:256
ds_read_b128 v[36:39], v92 offset:272
s_waitcnt lgkmcnt(0)
v_readfirstlane_b32 s60, v4
s_cmp_lt_u32 s60, 8
s_cbranch_scc1 L_sw
v_mov_b32 v41, s32
v_mov_b32 v43, s32
v_max3_f32 v44, v48, v49, v50
v_max3_f32 v45, v51, v52, v53
v_max3_f32 v44, v44, v54, v55
v_max_f32 v44, v44, v45
v_sub_f32 v48, v48, v44
v_sub_f32 v49, v49, v44
v_sub_f32 v50, v50, v44
v_sub_f32 v51, v51, v44
v_sub_f32 v52, v52, v44
v_sub_f32 v53, v53, v44
v_sub_f32 v54, v54, v44
v_sub_f32 v55, v55, v44
v_exp_f32 v48, v48
v_exp_f32 v49, v49
v_exp_f32 v50, v50
v_exp_f32 v51, v51
v_exp_f32 v52, v52
v_exp_f32 v53, v53
v_exp_f32 v54, v54
v_exp_f32 v55, v55
v_mul_f32 v32, v32, v48
v_mul_f32 v33, v33, v49
v_fmac_f32 v32, v34, v50
v_fmac_f32 v33, v35, v51
v_fmac_f32 v32, v36, v52
v_fmac_f32 v33, v37, v53
v_fmac_f32 v32, v38, v54
v_fmac_f32 v33, v39, v55
v_add_f32 v32, v32, v33
v_rcp_f32 v33, v32
v_log_f32 v42, v32
s_nop 0
v_add_f32 v42, v44, v42
s_mov_b64 exec, 1
buffer_store_dwordx2 v[42:43], v93, s[44:47], s24 offen
s_mov_b64 exec, -1
v_pk_mul_f32 v[48:49], v[48:49], v[32:33] op_sel:[0,1] op_sel_hi:[1,1]
v_pk_mul_f32 v[50:51], v[50:51], v[32:33] op_sel:[0,1] op_sel_hi:[1,1]
v_pk_mul_f32 v[52:53], v[52:53], v[32:33] op_sel:[0,1] op_sel_hi:[1,1]
v_pk_mul_f32 v[54:55], v[54:55], v[32:33] op_sel:[0,1] op_sel_hi:[1,1]
L_pw:
ds_read_b32 v4, v83 offset:16
s_waitcnt lgkmcnt(0)
v_readfirstlane_b32 s60, v4
s_cmp_lt_u32 s60, 8
s_cbranch_scc1 L_pw
ds_read_b64 v[16:17], v91 offset:19456
ds_read_b64 v[18:19], v91 offset:21504
ds_read_b64 v[20:21], v91 offset:23552
ds_read_b64 v[22:23], v91 offset:25600
ds_read_b64 v[24:25], v91 offset:27648
ds_read_b64 v[26:27], v91 offset:29696
ds_read_b64 v[28:29], v91 offset:31744
ds_read_b64 v[30:31], v91 offset:33792
s_waitcnt lgkmcnt(6)
v_pk_mul_f32 v[16:17], v[16:17], v[48:49] op_sel:[0,0] op_sel_hi:[1,0]
v_pk_mul_f32 v[18:19], v[18:19], v[48:49] op_sel:[0,1] op_sel_hi:[1,1]
s_waitcnt lgkmcnt(4)
v_pk_fma_f32 v[16:17], v[20:21], v[50:51], v[16:17] op_sel:[0,0,0] op_sel_hi:[1,0,1]
v_pk_fma_f32 v[18:19], v[22:23], v[50:51], v[18:19] op_sel:[0,1,0] op_sel_hi:[1,1,1]
s_waitcnt lgkmcnt(2)
v_pk_fma_f32 v[16:17], v[24:25], v[52:53], v[16:17] op_sel:[0,0,0] op_sel_hi:[1,0,1]
v_pk_fma_f32 v[18:19], v[26:27], v[52:53], v[18:19] op_sel:[0,1,0] op_sel_hi:[1,1,1]
s_waitcnt lgkmcnt(0)
v_pk_fma_f32 v[16:17], v[28:29], v[54:55], v[16:17] op_sel:[0,0,0] op_sel_hi:[1,0,1]
v_pk_fma_f32 v[18:19], v[30:31], v[54:55], v[18:19] op_sel:[0,1,0] op_sel_hi:[1,1,1]
v_pk_add_f32 v[16:17], v[16:17], v[18:19]
v_cvt_pk_bf16_f32 v40, v16, v17
buffer_store_dwordx2 v[40:41], v93, s[44:47], s23 offen
s_cmp_eq_u64 s[62:63], 0
s_cbranch_scc1 L_end
buffer_store_dwordx2 v[40:41], v93, s[44:47], s20 offen sc1
s_mov_b64 exec, 1
buffer_store_dwordx2 v[42:43], v93, s[44:47], s21 offen sc1
s_endpgm
L_A_hi:
s_cmp_lt_u32 s3, 5
s_cbranch_scc1 L_A_fin
s_cbranch_execz L_A_back
s_endpgm
L_A_fin:
s_cbranch_execz L_f0
buffer_load_dword v14, v85, s[48:51], s22 offen
s_setprio 3
s_barrier
s_sleep 16
L_f0:
s_cbranch_execz L_g3d
buffer_load_dwordx4 v[16:19], v84, s[44:47], s84 offen sc1
buffer_load_dwordx4 v[20:23], v84, s[44:47], s85 offen sc1
buffer_load_dwordx4 v[24:27], v84, s[44:47], s86 offen sc1
buffer_load_dwordx4 v[28:31], v84, s[44:47], s87 offen sc1
s_cbranch_execz L_g3d
s_branch L_g3c
L_g3r:
s_mov_b64 exec, vcc
s_sub_u32 s61, s61, 1
s_cmp_lt_i32 s61, 0
s_cbranch_scc1 L_g3k
s_sleep 1
buffer_load_dwordx4 v[16:19], v84, s[44:47], s84 offen sc1
buffer_load_dwordx4 v[20:23], v84, s[44:47], s85 offen sc1
buffer_load_dwordx4 v[24:27], v84, s[44:47], s86 offen sc1
buffer_load_dwordx4 v[28:31], v84, s[44:47], s87 offen sc1
L_g3c:
s_waitcnt vmcnt(0)
L_g3d:
v_xor_b32 v12, s32, v16
v_bitop3_b32 v12, v12, v17, s9 bitop3:0xf6
v_bitop3_b32 v12, v12, v18, s10 bitop3:0xf6
v_bitop3_b32 v12, v12, v19, s11 bitop3:0xf6
v_bitop3_b32 v12, v12, v20, s32 bitop3:0xf6
v_bitop3_b32 v12, v12, v21, s9 bitop3:0xf6
v_bitop3_b32 v12, v12, v22, s10 bitop3:0xf6
v_bitop3_b32 v12, v12, v23, s11 bitop3:0xf6
v_bitop3_b32 v12, v12, v24, s32 bitop3:0xf6
v_bitop3_b32 v12, v12, v25, s9 bitop3:0xf6
v_bitop3_b32 v12, v12, v26, s10 bitop3:0xf6
v_bitop3_b32 v12, v12, v27, s11 bitop3:0xf6
v_bitop3_b32 v12, v12, v28, s32 bitop3:0xf6
v_bitop3_b32 v12, v12, v29, s9 bitop3:0xf6
v_bitop3_b32 v12, v12, v30, s10 bitop3:0xf6
v_bitop3_b32 v12, v12, v31, s11 bitop3:0xf6
v_and_b32 v12, 0xff, v12
v_cmp_ne_u32 vcc, 0, v12
s_cbranch_vccnz L_g3r
L_g3k:
s_mov_b64 exec, s[92:93]
v_and_b32 v16, 0xffffff00, v16
v_and_b32 v17, 0xffffff00, v17
v_and_b32 v18, 0xffffff00, v18
v_and_b32 v19, 0xffffff00, v19
v_and_b32 v20, 0xffffff00, v20
v_and_b32 v21, 0xffffff00, v21
v_and_b32 v22, 0xffffff00, v22
v_and_b32 v23, 0xffffff00, v23
v_and_b32 v24, 0xffffff00, v24
v_and_b32 v25, 0xffffff00, v25
v_and_b32 v26, 0xffffff00, v26
v_and_b32 v27, 0xffffff00, v27
v_and_b32 v28, 0xffffff00, v28
v_and_b32 v29, 0xffffff00, v29
v_and_b32 v30, 0xffffff00, v30
v_and_b32 v31, 0xffffff00, v31
v_pk_add_f32 v[16:17], v[16:17], v[20:21]
v_pk_add_f32 v[18:19], v[18:19], v[22:23]
v_pk_add_f32 v[24:25], v[24:25], v[28:29]
v_pk_add_f32 v[26:27], v[26:27], v[30:31]
v_pk_add_f32 v[16:17], v[16:17], v[24:25]
v_pk_add_f32 v[18:19], v[18:19], v[26:27]
s_nop 0
v_add_f32_dpp v16, v16, v16 row_ror:8 row_mask:0xf bank_mask:0xf
v_add_f32_dpp v17, v17, v17 row_ror:8 row_mask:0xf bank_mask:0xf
v_add_f32_dpp v18, v18, v18 row_ror:8 row_mask:0xf bank_mask:0xf
v_add_f32_dpp v19, v19, v19 row_ror:8 row_mask:0xf bank_mask:0xf
v_mov_b32 v20, v16
v_mov_b32 v21, v17
v_mov_b32 v22, v18
v_mov_b32 v23, v19
v_permlane16_swap_b32 v16, v20
v_permlane16_swap_b32 v17, v21
v_permlane16_swap_b32 v18, v22
v_permlane16_swap_b32 v19, v23
v_pk_add_f32 v[18:19], v[18:19], v[22:23]
v_pk_add_f32 v[16:17], v[16:17], v[20:21]
v_mov_b32 v20, v16
v_mov_b32 v21, v17
v_mov_b32 v22, v18
v_mov_b32 v23, v19
v_permlane32_swap_b32 v16, v20
v_permlane32_swap_b32 v17, v21
v_permlane32_swap_b32 v18, v22
v_permlane32_swap_b32 v19, v23
v_pk_add_f32 v[18:19], v[18:19], v[22:23]
v_pk_add_f32 v[16:17], v[16:17], v[20:21]
v_cvt_pk_bf16_f32 v19, v18, v19
v_lshlrev_b32 v18, 16, v19
v_and_b32 v19, 0xffff0000, v19
v_mul_f32 v20, 0xbfb8aa3b, v18
v_mul_f32 v21, 0xbfb8aa3b, v19
v_exp_f32 v20, v20
v_exp_f32 v21, v21
v_cvt_pk_bf16_f32 v17, v16, v17
v_lshlrev_b32 v16, 16, v17
v_and_b32 v17, 0xffff0000, v17
v_add_f32 v20, 1.0, v20
v_add_f32 v21, 1.0, v21
v_rcp_f32 v20, v20
v_rcp_f32 v21, v21
v_and_b32 v15, 0xffff0000, v14
v_lshlrev_b32 v14, 16, v14
v_pk_mul_f32 v[18:19], v[18:19], v[20:21]
v_cvt_pk_bf16_f32 v19, v18, v19
v_lshlrev_b32 v18, 16, v19
v_and_b32 v19, 0xffff0000, v19
v_pk_mul_f32 v[16:17], v[16:17], v[18:19]
v_cvt_pk_bf16_f32 v17, v16, v17
v_lshlrev_b32 v16, 16, v17
v_and_b32 v17, 0xffff0000, v17
v_pk_add_f32 v[16:17], v[16:17], v[14:15]
v_cvt_pk_bf16_f32 v16, v16, v17
s_cbranch_execz L_A_back
s_mov_b64 exec, 0xff
buffer_store_dword v16, v85, s[56:59], s22 offen
s_cmp_lg_u32 s2, 0
s_cbranch_scc1 L_fin
s_mov_b64 exec, 1
v_mov_b32 v18, s32
v_mov_b32 v17, 0
buffer_store_dword v18, v17, s[44:47], 0 offen sc1
L_fin:
L_end:
s_endpgm
L_codeend:
.section .rodata,"a"
.p2align 6
.amdhsa_kernel recurrent_scan__sliding_block_cached__glu_gated_reglu__decode_kernel
  .amdhsa_next_free_vgpr 112
  .amdhsa_next_free_sgpr 100
  .amdhsa_accum_offset 112
  .amdhsa_group_segment_fixed_size 0
  .amdhsa_kernarg_size 96
  .amdhsa_user_sgpr_count 2
  .amdhsa_user_sgpr_kernarg_segment_ptr 1
  .amdhsa_system_sgpr_workgroup_id_x 1
.end_amdhsa_kernel
```
